```python
import torch

def _softmax(x, axis=-1):
    return torch.softmax(x, dim=axis)
def _gelu(x):
    return torch.nn.functional.gelu(x, approximate="tanh")
def _silu(x):
    return torch.nn.functional.silu(x)
def _sigmoid(x):
    return torch.sigmoid(x)
def _layernorm(x, axis=-1, eps=1e-5):
    m = x.mean(dim=axis, keepdim=True)
    v = x.var(dim=axis, keepdim=True, unbiased=False)
    return (x - m) / torch.sqrt(v + eps)
def _scatter_add(tgt, idx, src, axis=0):
    return tgt.clone().index_add_(axis, idx, src)
def _segment_sum(src, seg, n):
    out = torch.zeros((n,) + src.shape[1:], dtype=src.dtype)
    return out.index_add_(0, seg, src)
def _pad(x, pw):
    flat = tuple(v for pair in reversed(pw) for v in pair)
    return torch.nn.functional.pad(x, flat)

kernel_name = 'standalone__kv_cache_quant_int4_int2_kv_with_per_channel_or_per_token_scales__sampling'

def setup_inputs():

    _w = (lambda a: (lambda t: t.to(torch.bfloat16) if t.is_floating_point() else t)(torch.as_tensor(a)))
    B = 32
    Sq = 4
    Skv = 2048
    Hq = 32
    Hkv = 16
    Dh = 128
    bits = 8
    G = 64
    if G <= 0 or G >= Skv:
        G = max(1, Skv // 2)
    Skv = (Skv // G) * G
    ngk = Skv // G
    qmax = (1 << bits) - 1
    return {
        "q": _w((lambda *s: torch.randn(*s, dtype=torch.bfloat16) * 0.2)(B, Hq, Sq, Dh)),
        "qk": _w(torch.randint(0, qmax + 1, (B, Hkv, Skv, Dh)).to(torch.int32)),
        "qv": _w(torch.randint(0, qmax + 1, (B, Hkv, Skv, Dh)).to(torch.int32)),
        "k_scales": _w(torch.abs((lambda *s: torch.randn(*s, dtype=torch.bfloat16) * 0.2)(B, Hkv, ngk, Dh)) * 0.05 + 0.02),
        "k_zeros": _w((lambda *s: torch.randn(*s, dtype=torch.bfloat16) * 0.2)(B, Hkv, ngk, Dh) + float(qmax) / 2.0),
        "v_scales": _w(torch.abs((lambda *s: torch.randn(*s, dtype=torch.bfloat16) * 0.05)(B, Hkv, Skv, 1)) * 0.05 + 0.02),
        "v_zeros": _w((lambda *s: torch.randn(*s, dtype=torch.bfloat16) * 0.05)(B, Hkv, Skv, 1) + float(qmax) / 2.0),
    }

def reference(q, qk, qv, k_scales, k_zeros, v_scales, v_zeros):
    B, Hq, Sq, Dh = q.shape
    Hkv, Skv = qk.shape[1], qk.shape[2]
    ngk = k_scales.shape[2]
    G = Skv // ngk
    ks = (lambda x, n, axis: torch.repeat_interleave(x, n, dim=axis))(k_scales, G, axis=2)
    kz = (lambda x, n, axis: torch.repeat_interleave(x, n, dim=axis))(k_zeros, G, axis=2)
    k = ((lambda x, dt: x.to(dt))(qk, q.dtype) - kz) * ks
    v = ((lambda x, dt: x.to(dt))(qv, q.dtype) - v_zeros) * v_scales
    rep = Hq // Hkv
    if rep > 1:
        k = (lambda x, n, axis: torch.repeat_interleave(x, n, dim=axis))(k, rep, axis=1)
        v = (lambda x, n, axis: torch.repeat_interleave(x, n, dim=axis))(v, rep, axis=1)
    scale = float(Dh) ** -0.5
    logits = torch.einsum("bhqd,bhkd->bhqk", q, k) * scale
    p = _softmax(logits, axis=-1)
    o = torch.einsum("bhqk,bhkd->bhqd", p, v)
    return o
```

```asm
; @launch grid=(256,1,1) block=(256,1,1) lds=149056
.amdgcn_target "amdgcn-amd-amdhsa--gfx950"
.text
.globl standalone__kv_cache_quant_int4_int2_kv_with_per_channel_or_per_token_scales__sampling_kernel
.p2align 8
.type standalone__kv_cache_quant_int4_int2_kv_with_per_channel_or_per_token_scales__sampling_kernel,@function
standalone__kv_cache_quant_int4_int2_kv_with_per_channel_or_per_token_scales__sampling_kernel:
  s_load_dwordx16 s[16:31], s[0:1], 0
  s_cmp_ge_u32 s2, 256
  s_cbranch_scc1 L_done
  v_lshrrev_b32 v11, 6, v0
  v_and_b32 v1, 63, v0
  v_readfirstlane_b32 s3, v11
  v_lshrrev_b32 v13, 4, v1
  v_and_b32 v15, 1, v1
  v_bfe_u32 v11, v1, 1, 3
  v_lshlrev_b32 v132, 9, v11
  v_lshl_add_u32 v132, v13, 5, v132
  v_lshl_add_u32 v132, v15, 4, v132
  v_add_u32 v133, 128, v132
  v_add_u32 v134, 256, v132
  v_add_u32 v135, 384, v132
  s_lshl_b32 s65, s3, 13
  s_mov_b32 s4, s65
  s_lshl_b32 s9, s2, 21
  s_mov_b32 s34, 2097152
  s_mov_b32 s35, 0x20000
  s_waitcnt lgkmcnt(0)
  v_lshlrev_b32 v4, 4, v13
  v_lshl_add_u32 v4, v15, 3, v4
  v_add_u32 v5, 16384, v4
  v_bfe_u32 v15, v1, 3, 1
  v_lshlrev_b32 v137, 4, v13
  v_lshl_add_u32 v137, v15, 3, v137
  v_and_b32 v11, 7, v1
  v_lshl_add_u32 v137, v11, 8, v137
  v_lshlrev_b32 v138, 4, v1
  s_lshl_b32 s11, s2, 14
  s_lshl_b32 s12, s2, 13
  s_lshl_b32 s13, s2, 12
  s_lshl_b32 s14, s3, 10
  s_add_u32 s44, s22, s11
  s_addc_u32 s45, s23, 0
  s_and_b32 s45, s45, 0xffff
  s_mov_b32 s46, 16384
  s_mov_b32 s47, 0x20000
  s_add_u32 s15, s14, 0
  s_add_u32 m0, s15, 0
  s_nop 0
  buffer_load_dwordx4 v138, s[44:47], s15 offen nt lds
  s_add_u32 s48, s24, s11
  s_addc_u32 s49, s25, 0
  s_and_b32 s49, s49, 0xffff
  s_mov_b32 s50, 16384
  s_mov_b32 s51, 0x20000
  s_add_u32 s15, s14, 0
  s_add_u32 m0, s15, 16384
  s_nop 0
  buffer_load_dwordx4 v138, s[48:51], s15 offen nt lds
  s_add_u32 s40, s16, s13
  s_addc_u32 s41, s17, 0
  s_and_b32 s41, s41, 0xffff
  s_mov_b32 s42, 4096
  s_mov_b32 s43, 0x20000
  buffer_load_dwordx2 v[32:33], v137, s[40:43], 0 offen offset:0 nt
  buffer_load_dwordx2 v[34:35], v137, s[40:43], 0 offen offset:64 nt
  buffer_load_dwordx2 v[36:37], v137, s[40:43], 0 offen offset:128 nt
  buffer_load_dwordx2 v[38:39], v137, s[40:43], 0 offen offset:192 nt
  s_add_u32 s32, s18, s9
  s_addc_u32 s33, s19, 0
  s_and_b32 s33, s33, 0xffff
  buffer_load_dwordx4 v[160:163], v132, s[32:35], s4 offen nt
  buffer_load_dwordx4 v[164:167], v133, s[32:35], s4 offen nt
  buffer_load_dwordx4 v[168:171], v134, s[32:35], s4 offen nt
  buffer_load_dwordx4 v[172:175], v135, s[32:35], s4 offen nt
  s_add_u32 s4, s4, 4096
  buffer_load_dwordx4 v[176:179], v132, s[32:35], s4 offen nt
  buffer_load_dwordx4 v[180:183], v133, s[32:35], s4 offen nt
  buffer_load_dwordx4 v[184:187], v134, s[32:35], s4 offen nt
  buffer_load_dwordx4 v[188:191], v135, s[32:35], s4 offen nt
  s_add_u32 s4, s4, 28672
  buffer_load_dwordx4 v[192:195], v132, s[32:35], s4 offen nt
  buffer_load_dwordx4 v[196:199], v133, s[32:35], s4 offen nt
  buffer_load_dwordx4 v[200:203], v134, s[32:35], s4 offen nt
  buffer_load_dwordx4 v[204:207], v135, s[32:35], s4 offen nt
  s_add_u32 s4, s4, 4096
  buffer_load_dwordx4 v[208:211], v132, s[32:35], s4 offen nt
  buffer_load_dwordx4 v[212:215], v133, s[32:35], s4 offen nt
  buffer_load_dwordx4 v[216:219], v134, s[32:35], s4 offen nt
  buffer_load_dwordx4 v[220:223], v135, s[32:35], s4 offen nt
  s_add_u32 s4, s4, 28672
  s_add_u32 s52, s26, s12
  s_addc_u32 s53, s27, 0
  s_and_b32 s53, s53, 0xffff
  s_mov_b32 s54, 8192
  s_mov_b32 s55, 0x20000
  s_add_u32 s56, s28, s12
  s_addc_u32 s57, s29, 0
  s_and_b32 s57, s57, 0xffff
  s_mov_b32 s58, 8192
  s_mov_b32 s59, 0x20000
  v_add_u32 v7, -1, v15
  v_not_b32 v8, v7
  s_lshl_b32 s10, s3, 5
  s_add_u32 s10, s10, 32768
  v_lshl_add_u32 v6, v13, 2, s10
  s_mul_i32 s10, s3, 16384
  s_add_u32 s10, s10, 49152
  v_lshl_add_u32 v2, v13, 6, s10
  v_lshl_add_u32 v2, v11, 3, v2
  v_lshlrev_b32 v149, 4, v11
  v_add_u32 v149, 148480, v149
  s_lshl_b32 s10, s3, 2
  v_add_u32 v148, s10, v149
  s_mul_i32 s10, s3, 4224
  s_add_u32 s10, s10, 114688
  v_mul_u32_u24 v150, 528, v11
  v_lshl_add_u32 v150, v15, 8, v150
  v_lshl_add_u32 v150, v13, 6, v150
  v_add_u32 v150, s10, v150
  v_and_b32 v11, 15, v1
  v_lshlrev_b32 v136, 10, v13
  v_lshl_add_u32 v136, v11, 4, v136
  v_lshrrev_b32 v11, 5, v0
  v_and_b32 v13, 31, v0
  v_mul_u32_u24 v151, 528, v11
  v_lshl_add_u32 v151, v13, 4, v151
  v_add_u32 v151, 114688, v151
  v_lshlrev_b32 v152, 3, v0
  v_mov_b32 v153, 148992
  v_mov_b32 v155, 148992
  v_mov_b32 v139, 1
  v_mov_b32 v10, 0
  v_mov_b32 v11, 0
  ds_write_b64 v153, v[10:11]
  ds_write_b64 v153, v[10:11] offset:8
  s_add_u32 s36, s20, s9
  s_addc_u32 s37, s21, 0
  s_and_b32 s37, s37, 0xffff
  s_mov_b32 s7, 0x3fb8aa3b
  s_mov_b32 s8, 0xbfb8aa3b
  s_mov_b32 s38, 0x3db504f3
  s_mov_b32 s39, 0x3db504f3
  s_add_u32 s60, s30, s13
  s_addc_u32 s61, s31, 0
  s_and_b32 s61, s61, 0xffff
  s_mov_b32 s62, 4096
  s_mov_b32 s63, 0x20000
  s_mov_b32 s6, 0
  v_mov_b32 v9, 0xff800000
  v_mov_b32 v14, 0x7f800000
  s_waitcnt vmcnt(16) lgkmcnt(0)
  s_barrier
  ds_read2_b64 v[48:51], v5 offset0:0 offset1:8
  ds_read2_b64 v[52:55], v5 offset0:16 offset1:24
  ds_read2_b64 v[40:43], v4 offset0:0 offset1:8
  ds_read2_b64 v[44:47], v4 offset0:16 offset1:24
  v_add_u32 v4, 256, v4
  v_add_u32 v5, 256, v5
  s_nop 1
L_k:
  s_cmp_lg_u32 s6, 16
  s_cbranch_scc1 L_k1
  v_mov_b32 v13, v10
  ds_write_b32 v148, v14 offset:0
  s_nop 0
  v_permlane32_swap_b32 v10, v13
  v_add_f32 v10, v10, v13
  v_mov_b32 v13, v10
  s_nop 1
  v_permlane16_swap_b32 v10, v13
  v_add_f32 v13, v10, v13
  ds_write_b32 v148, v13 offset:128
  s_mov_b64 exec, 1
  ds_add_u32 v153, v139 offset:0
  s_mov_b64 exec, -1
  v_mov_b32 v9, 0xff800000
  v_mov_b32 v14, 0x7f800000
  v_mov_b32 v10, 0
  v_mov_b32 v32, v140
  v_mov_b32 v33, v141
  v_mov_b32 v34, v142
  v_mov_b32 v35, v143
  v_mov_b32 v36, v144
  v_mov_b32 v37, v145
  v_mov_b32 v38, v146
  v_mov_b32 v39, v147
  s_nop 1
L_k1:
  s_waitcnt lgkmcnt(0)
  v_lshlrev_b32 v56, 16, v48
  v_and_b32 v57, 0xffff0000, v48
  v_lshlrev_b32 v58, 16, v49
  v_and_b32 v59, 0xffff0000, v49
  v_lshlrev_b32 v60, 16, v50
  v_and_b32 v61, 0xffff0000, v50
  v_lshlrev_b32 v62, 16, v51
  v_and_b32 v63, 0xffff0000, v51
  v_lshlrev_b32 v64, 16, v52
  v_and_b32 v65, 0xffff0000, v52
  v_lshlrev_b32 v66, 16, v53
  v_and_b32 v67, 0xffff0000, v53
  v_lshlrev_b32 v68, 16, v54
  v_and_b32 v69, 0xffff0000, v54
  v_lshlrev_b32 v70, 16, v55
  v_and_b32 v71, 0xffff0000, v55
  v_lshlrev_b32 v16, 16, v40
  v_and_b32 v17, 0xffff0000, v40
  v_lshlrev_b32 v18, 16, v41
  v_and_b32 v19, 0xffff0000, v41
  v_lshlrev_b32 v20, 16, v42
  v_and_b32 v21, 0xffff0000, v42
  v_lshlrev_b32 v22, 16, v43
  v_and_b32 v23, 0xffff0000, v43
  v_lshlrev_b32 v24, 16, v44
  v_and_b32 v25, 0xffff0000, v44
  v_lshlrev_b32 v26, 16, v45
  v_and_b32 v27, 0xffff0000, v45
  v_lshlrev_b32 v28, 16, v46
  v_and_b32 v29, 0xffff0000, v46
  v_lshlrev_b32 v30, 16, v47
  v_and_b32 v31, 0xffff0000, v47
  ds_read2_b64 v[48:51], v5 offset0:0 offset1:8
  ds_read2_b64 v[52:55], v5 offset0:16 offset1:24
  ds_read2_b64 v[40:43], v4 offset0:0 offset1:8
  ds_read2_b64 v[44:47], v4 offset0:16 offset1:24
  v_add_u32 v4, 256, v4
  v_add_u32 v5, 256, v5
  s_waitcnt vmcnt(8)
  s_cmp_eq_u32 s6, 0
  s_cbranch_scc1 L_k3
  s_waitcnt vmcnt(0)
L_k3:
  v_cvt_f32_i32 v160, v160
  v_cvt_f32_i32 v161, v161
  v_cvt_f32_i32 v162, v162
  v_cvt_f32_i32 v163, v163
  v_pk_add_f32 v[160:161], v[160:161], v[56:57] neg_lo:[0,1] neg_hi:[0,1]
  v_pk_add_f32 v[162:163], v[162:163], v[58:59] neg_lo:[0,1] neg_hi:[0,1]
  v_cvt_pk_bf16_f32 v158, v160, v161
  v_cvt_pk_bf16_f32 v159, v162, v163
  v_lshlrev_b32 v160, 16, v158
  v_and_b32 v161, 0xffff0000, v158
  v_lshlrev_b32 v162, 16, v159
  v_and_b32 v163, 0xffff0000, v159
  v_pk_mul_f32 v[160:161], v[160:161], v[16:17]
  v_pk_mul_f32 v[162:163], v[162:163], v[18:19]
  v_cvt_pk_bf16_f32 v100, v160, v161
  v_cvt_pk_bf16_f32 v101, v162, v163
  v_cvt_f32_i32 v164, v164
  v_cvt_f32_i32 v165, v165
  v_cvt_f32_i32 v166, v166
  v_cvt_f32_i32 v167, v167
  v_pk_add_f32 v[164:165], v[164:165], v[60:61] neg_lo:[0,1] neg_hi:[0,1]
  v_pk_add_f32 v[166:167], v[166:167], v[62:63] neg_lo:[0,1] neg_hi:[0,1]
  v_cvt_pk_bf16_f32 v158, v164, v165
  v_cvt_pk_bf16_f32 v159, v166, v167
  v_lshlrev_b32 v164, 16, v158
  v_and_b32 v165, 0xffff0000, v158
  v_lshlrev_b32 v166, 16, v159
  v_and_b32 v167, 0xffff0000, v159
  v_pk_mul_f32 v[164:165], v[164:165], v[20:21]
  v_pk_mul_f32 v[166:167], v[166:167], v[22:23]
  v_cvt_pk_bf16_f32 v102, v164, v165
  v_cvt_pk_bf16_f32 v103, v166, v167
  s_nop 1
  v_mfma_f32_16x16x32_bf16 v[108:111], v[100:103], v[32:35], 0
  v_cvt_f32_i32 v168, v168
  v_cvt_f32_i32 v169, v169
  v_cvt_f32_i32 v170, v170
  v_cvt_f32_i32 v171, v171
  v_pk_add_f32 v[168:169], v[168:169], v[64:65] neg_lo:[0,1] neg_hi:[0,1]
  v_pk_add_f32 v[170:171], v[170:171], v[66:67] neg_lo:[0,1] neg_hi:[0,1]
  v_cvt_pk_bf16_f32 v158, v168, v169
  v_cvt_pk_bf16_f32 v159, v170, v171
  v_lshlrev_b32 v168, 16, v158
  v_and_b32 v169, 0xffff0000, v158
  v_lshlrev_b32 v170, 16, v159
  v_and_b32 v171, 0xffff0000, v159
  v_pk_mul_f32 v[168:169], v[168:169], v[24:25]
  v_pk_mul_f32 v[170:171], v[170:171], v[26:27]
  v_cvt_pk_bf16_f32 v104, v168, v169
  v_cvt_pk_bf16_f32 v105, v170, v171
  v_cvt_f32_i32 v172, v172
  v_cvt_f32_i32 v173, v173
  v_cvt_f32_i32 v174, v174
  v_cvt_f32_i32 v175, v175
  v_pk_add_f32 v[172:173], v[172:173], v[68:69] neg_lo:[0,1] neg_hi:[0,1]
  v_pk_add_f32 v[174:175], v[174:175], v[70:71] neg_lo:[0,1] neg_hi:[0,1]
  v_cvt_pk_bf16_f32 v158, v172, v173
  v_cvt_pk_bf16_f32 v159, v174, v175
  v_lshlrev_b32 v172, 16, v158
  v_and_b32 v173, 0xffff0000, v158
  v_lshlrev_b32 v174, 16, v159
  v_and_b32 v175, 0xffff0000, v159
  v_pk_mul_f32 v[172:173], v[172:173], v[28:29]
  v_pk_mul_f32 v[174:175], v[174:175], v[30:31]
  v_cvt_pk_bf16_f32 v106, v172, v173
  v_cvt_pk_bf16_f32 v107, v174, v175
  s_nop 1
  v_mfma_f32_16x16x32_bf16 v[108:111], v[104:107], v[36:39], v[108:111]
  v_cvt_f32_i32 v176, v176
  v_cvt_f32_i32 v177, v177
  v_cvt_f32_i32 v178, v178
  v_cvt_f32_i32 v179, v179
  v_pk_add_f32 v[176:177], v[176:177], v[56:57] neg_lo:[0,1] neg_hi:[0,1]
  v_pk_add_f32 v[178:179], v[178:179], v[58:59] neg_lo:[0,1] neg_hi:[0,1]
  v_cvt_pk_bf16_f32 v158, v176, v177
  v_cvt_pk_bf16_f32 v159, v178, v179
  v_lshlrev_b32 v176, 16, v158
  v_and_b32 v177, 0xffff0000, v158
  v_lshlrev_b32 v178, 16, v159
  v_and_b32 v179, 0xffff0000, v159
  v_pk_mul_f32 v[176:177], v[176:177], v[16:17]
  v_pk_mul_f32 v[178:179], v[178:179], v[18:19]
  v_cvt_pk_bf16_f32 v100, v176, v177
  v_cvt_pk_bf16_f32 v101, v178, v179
  v_cvt_f32_i32 v180, v180
  v_cvt_f32_i32 v181, v181
  v_cvt_f32_i32 v182, v182
  v_cvt_f32_i32 v183, v183
  v_pk_add_f32 v[180:181], v[180:181], v[60:61] neg_lo:[0,1] neg_hi:[0,1]
  v_pk_add_f32 v[182:183], v[182:183], v[62:63] neg_lo:[0,1] neg_hi:[0,1]
  v_cvt_pk_bf16_f32 v158, v180, v181
  v_cvt_pk_bf16_f32 v159, v182, v183
  v_lshlrev_b32 v180, 16, v158
  v_and_b32 v181, 0xffff0000, v158
  v_lshlrev_b32 v182, 16, v159
  v_and_b32 v183, 0xffff0000, v159
  v_pk_mul_f32 v[180:181], v[180:181], v[20:21]
  v_pk_mul_f32 v[182:183], v[182:183], v[22:23]
  v_cvt_pk_bf16_f32 v102, v180, v181
  v_cvt_pk_bf16_f32 v103, v182, v183
  s_nop 1
  v_mfma_f32_16x16x32_bf16 v[112:115], v[100:103], v[32:35], 0
  v_cvt_f32_i32 v184, v184
  v_cvt_f32_i32 v185, v185
  v_cvt_f32_i32 v186, v186
  v_cvt_f32_i32 v187, v187
  v_pk_add_f32 v[184:185], v[184:185], v[64:65] neg_lo:[0,1] neg_hi:[0,1]
  v_pk_add_f32 v[186:187], v[186:187], v[66:67] neg_lo:[0,1] neg_hi:[0,1]
  v_cvt_pk_bf16_f32 v158, v184, v185
  v_cvt_pk_bf16_f32 v159, v186, v187
  s_cmp_eq_u32 s6, 0
  s_cbranch_scc1 L_rest
  buffer_load_dwordx4 v[192:195], v132, s[32:35], s4 offen nt
  buffer_load_dwordx4 v[196:199], v133, s[32:35], s4 offen nt
  buffer_load_dwordx4 v[200:203], v134, s[32:35], s4 offen nt
  buffer_load_dwordx4 v[204:207], v135, s[32:35], s4 offen nt
  s_add_u32 s4, s4, 4096
  buffer_load_dwordx4 v[208:211], v132, s[32:35], s4 offen nt
  buffer_load_dwordx4 v[212:215], v133, s[32:35], s4 offen nt
  buffer_load_dwordx4 v[216:219], v134, s[32:35], s4 offen nt
  buffer_load_dwordx4 v[220:223], v135, s[32:35], s4 offen nt
  s_add_u32 s4, s4, 28672
L_k4:
  v_lshlrev_b32 v184, 16, v158
  v_and_b32 v185, 0xffff0000, v158
  v_lshlrev_b32 v186, 16, v159
  v_and_b32 v187, 0xffff0000, v159
  v_pk_mul_f32 v[184:185], v[184:185], v[24:25]
  v_pk_mul_f32 v[186:187], v[186:187], v[26:27]
  v_cvt_pk_bf16_f32 v104, v184, v185
  v_cvt_pk_bf16_f32 v105, v186, v187
  v_cvt_f32_i32 v188, v188
  v_cvt_f32_i32 v189, v189
  v_cvt_f32_i32 v190, v190
  v_cvt_f32_i32 v191, v191
  v_pk_add_f32 v[188:189], v[188:189], v[68:69] neg_lo:[0,1] neg_hi:[0,1]
  v_pk_add_f32 v[190:191], v[190:191], v[70:71] neg_lo:[0,1] neg_hi:[0,1]
  v_cvt_pk_bf16_f32 v158, v188, v189
  v_cvt_pk_bf16_f32 v159, v190, v191
  v_lshlrev_b32 v188, 16, v158
  v_and_b32 v189, 0xffff0000, v158
  v_lshlrev_b32 v190, 16, v159
  v_and_b32 v191, 0xffff0000, v159
  v_pk_mul_f32 v[188:189], v[188:189], v[28:29]
  v_pk_mul_f32 v[190:191], v[190:191], v[30:31]
  v_cvt_pk_bf16_f32 v106, v188, v189
  v_cvt_pk_bf16_f32 v107, v190, v191
  s_nop 1
  v_mfma_f32_16x16x32_bf16 v[112:115], v[104:107], v[36:39], v[112:115]
  v_add_f32_dpp v100, v109, v108 row_ror:8 row_mask:0xf bank_mask:0x3
  v_add_f32_dpp v100, v108, v109 row_ror:8 row_mask:0xf bank_mask:0xc
  v_add_f32_dpp v101, v111, v110 row_ror:8 row_mask:0xf bank_mask:0x3
  v_add_f32_dpp v101, v110, v111 row_ror:8 row_mask:0xf bank_mask:0xc
  s_nop 3
  v_add_f32_dpp v102, v113, v112 row_ror:8 row_mask:0xf bank_mask:0x3
  v_add_f32_dpp v102, v112, v113 row_ror:8 row_mask:0xf bank_mask:0xc
  v_add_f32_dpp v103, v115, v114 row_ror:8 row_mask:0xf bank_mask:0x3
  v_add_f32_dpp v103, v114, v115 row_ror:8 row_mask:0xf bank_mask:0xc
  v_cvt_pk_bf16_f32 v158, v100, v101
  v_cvt_pk_bf16_f32 v159, v102, v103
  v_lshlrev_b32 v100, 16, v158
  v_and_b32 v101, 0xffff0000, v158
  v_lshlrev_b32 v102, 16, v159
  v_and_b32 v103, 0xffff0000, v159
  v_pk_mul_f32 v[100:101], v[100:101], s[38:39]
  v_pk_mul_f32 v[102:103], v[102:103], s[38:39]
  v_cvt_pk_bf16_f32 v112, v100, v101
  v_cvt_pk_bf16_f32 v113, v102, v103
  v_lshlrev_b32 v100, 16, v112
  v_and_b32 v101, 0xffff0000, v112
  v_lshlrev_b32 v102, 16, v113
  v_and_b32 v103, 0xffff0000, v113
  ds_write_b64 v2, v[112:113]
  v_max3_f32 v11, v100, v101, v102
  v_max3_f32 v11, v11, v103, v9
  v_mov_b32 v13, v11
  v_mov_b32 v15, v14
  v_add_u32 v2, 256, v2
  v_permlane32_swap_b32 v11, v13
  v_max_f32 v11, v11, v13
  v_mov_b32 v13, v11
  s_nop 1
  v_permlane16_swap_b32 v11, v13
  v_max_f32 v9, v11, v13
  v_mul_f32 v14, s8, v9
  v_sub_f32 v12, v14, v15
  v_exp_f32 v12, v12
  v_fma_f32 v104, v100, s7, v14
  v_fma_f32 v105, v101, s7, v14
  v_fma_f32 v106, v102, s7, v14
  v_fma_f32 v107, v103, s7, v14
  v_exp_f32 v104, v104
  v_exp_f32 v105, v105
  v_exp_f32 v106, v106
  v_exp_f32 v107, v107
  v_add_f32 v11, v104, v105
  v_add_f32 v13, v106, v107
  v_add_f32 v11, v11, v13
  v_fma_f32 v10, v10, v12, v11
  s_cmp_lg_u32 s6, 1
  s_cbranch_scc1 L_k6
  s_mov_b64 exec, 1
  ds_add_u32 v153, v139 offset:12
  s_mov_b64 exec, -1
L_k6:
  s_cmp_lg_u32 s6, 6
  s_cbranch_scc1 L_k7
L_wr:
  ds_read_b32 v154, v153 offset:12
  s_waitcnt lgkmcnt(0)
  v_readfirstlane_b32 s12, v154
  s_nop 1
  s_cmp_lt_u32 s12, 4
  s_cbranch_scc1 L_wr
  s_nop 0
L_k7:
  s_cmp_lg_u32 s6, 31
  s_cbranch_scc1 L_k2
  s_mov_b32 s32, s36
  s_mov_b32 s33, s37
  s_mov_b32 s4, s65
  v_add_u32 v132, 0, v136
  v_add_u32 v133, 512, v136
  v_add_u32 v134, 256, v136
  v_add_u32 v135, 768, v136
  s_nop 1
L_k2:
  s_waitcnt lgkmcnt(0)
  v_lshlrev_b32 v56, 16, v48
  v_and_b32 v57, 0xffff0000, v48
  v_lshlrev_b32 v58, 16, v49
  v_and_b32 v59, 0xffff0000, v49
  v_lshlrev_b32 v60, 16, v50
  v_and_b32 v61, 0xffff0000, v50
  v_lshlrev_b32 v62, 16, v51
  v_and_b32 v63, 0xffff0000, v51
  v_lshlrev_b32 v64, 16, v52
  v_and_b32 v65, 0xffff0000, v52
  v_lshlrev_b32 v66, 16, v53
  v_and_b32 v67, 0xffff0000, v53
  v_lshlrev_b32 v68, 16, v54
  v_and_b32 v69, 0xffff0000, v54
  v_lshlrev_b32 v70, 16, v55
  v_and_b32 v71, 0xffff0000, v55
  v_lshlrev_b32 v16, 16, v40
  v_and_b32 v17, 0xffff0000, v40
  v_lshlrev_b32 v18, 16, v41
  v_and_b32 v19, 0xffff0000, v41
  v_lshlrev_b32 v20, 16, v42
  v_and_b32 v21, 0xffff0000, v42
  v_lshlrev_b32 v22, 16, v43
  v_and_b32 v23, 0xffff0000, v43
  v_lshlrev_b32 v24, 16, v44
  v_and_b32 v25, 0xffff0000, v44
  v_lshlrev_b32 v26, 16, v45
  v_and_b32 v27, 0xffff0000, v45
  v_lshlrev_b32 v28, 16, v46
  v_and_b32 v29, 0xffff0000, v46
  v_lshlrev_b32 v30, 16, v47
  v_and_b32 v31, 0xffff0000, v47
  ds_read2_b64 v[48:51], v5 offset0:0 offset1:8
  ds_read2_b64 v[52:55], v5 offset0:16 offset1:24
  ds_read2_b64 v[40:43], v4 offset0:0 offset1:8
  ds_read2_b64 v[44:47], v4 offset0:16 offset1:24
  v_add_u32 v4, 256, v4
  v_add_u32 v5, 256, v5
  s_waitcnt vmcnt(14)
  s_cmp_eq_u32 s6, 0
  s_cbranch_scc1 L_k5
  s_waitcnt vmcnt(0)
L_k5:
  v_cvt_f32_i32 v192, v192
  v_cvt_f32_i32 v193, v193
  v_cvt_f32_i32 v194, v194
  v_cvt_f32_i32 v195, v195
  v_pk_add_f32 v[192:193], v[192:193], v[56:57] neg_lo:[0,1] neg_hi:[0,1]
  v_pk_add_f32 v[194:195], v[194:195], v[58:59] neg_lo:[0,1] neg_hi:[0,1]
  v_cvt_pk_bf16_f32 v158, v192, v193
  v_cvt_pk_bf16_f32 v159, v194, v195
  v_lshlrev_b32 v192, 16, v158
  v_and_b32 v193, 0xffff0000, v158
  v_lshlrev_b32 v194, 16, v159
  v_and_b32 v195, 0xffff0000, v159
  v_pk_mul_f32 v[192:193], v[192:193], v[16:17]
  v_pk_mul_f32 v[194:195], v[194:195], v[18:19]
  v_cvt_pk_bf16_f32 v100, v192, v193
  v_cvt_pk_bf16_f32 v101, v194, v195
  v_cvt_f32_i32 v196, v196
  v_cvt_f32_i32 v197, v197
  v_cvt_f32_i32 v198, v198
  v_cvt_f32_i32 v199, v199
  v_pk_add_f32 v[196:197], v[196:197], v[60:61] neg_lo:[0,1] neg_hi:[0,1]
  v_pk_add_f32 v[198:199], v[198:199], v[62:63] neg_lo:[0,1] neg_hi:[0,1]
  v_cvt_pk_bf16_f32 v158, v196, v197
  v_cvt_pk_bf16_f32 v159, v198, v199
  v_lshlrev_b32 v196, 16, v158
  v_and_b32 v197, 0xffff0000, v158
  v_lshlrev_b32 v198, 16, v159
  v_and_b32 v199, 0xffff0000, v159
  v_pk_mul_f32 v[196:197], v[196:197], v[20:21]
  v_pk_mul_f32 v[198:199], v[198:199], v[22:23]
  v_cvt_pk_bf16_f32 v102, v196, v197
  v_cvt_pk_bf16_f32 v103, v198, v199
  s_nop 1
  v_mfma_f32_16x16x32_bf16 v[108:111], v[100:103], v[32:35], 0
  v_cvt_f32_i32 v200, v200
  v_cvt_f32_i32 v201, v201
  v_cvt_f32_i32 v202, v202
  v_cvt_f32_i32 v203, v203
  v_pk_add_f32 v[200:201], v[200:201], v[64:65] neg_lo:[0,1] neg_hi:[0,1]
  v_pk_add_f32 v[202:203], v[202:203], v[66:67] neg_lo:[0,1] neg_hi:[0,1]
  v_cvt_pk_bf16_f32 v158, v200, v201
  v_cvt_pk_bf16_f32 v159, v202, v203
  v_lshlrev_b32 v200, 16, v158
  v_and_b32 v201, 0xffff0000, v158
  v_lshlrev_b32 v202, 16, v159
  v_and_b32 v203, 0xffff0000, v159
  v_pk_mul_f32 v[200:201], v[200:201], v[24:25]
  v_pk_mul_f32 v[202:203], v[202:203], v[26:27]
  v_cvt_pk_bf16_f32 v104, v200, v201
  v_cvt_pk_bf16_f32 v105, v202, v203
  v_cvt_f32_i32 v204, v204
  v_cvt_f32_i32 v205, v205
  v_cvt_f32_i32 v206, v206
  v_cvt_f32_i32 v207, v207
  v_pk_add_f32 v[204:205], v[204:205], v[68:69] neg_lo:[0,1] neg_hi:[0,1]
  v_pk_add_f32 v[206:207], v[206:207], v[70:71] neg_lo:[0,1] neg_hi:[0,1]
  v_cvt_pk_bf16_f32 v158, v204, v205
  v_cvt_pk_bf16_f32 v159, v206, v207
  v_lshlrev_b32 v204, 16, v158
  v_and_b32 v205, 0xffff0000, v158
  v_lshlrev_b32 v206, 16, v159
  v_and_b32 v207, 0xffff0000, v159
  v_pk_mul_f32 v[204:205], v[204:205], v[28:29]
  v_pk_mul_f32 v[206:207], v[206:207], v[30:31]
  v_cvt_pk_bf16_f32 v106, v204, v205
  v_cvt_pk_bf16_f32 v107, v206, v207
  s_nop 1
  v_mfma_f32_16x16x32_bf16 v[108:111], v[104:107], v[36:39], v[108:111]
  v_cvt_f32_i32 v208, v208
  v_cvt_f32_i32 v209, v209
  v_cvt_f32_i32 v210, v210
  v_cvt_f32_i32 v211, v211
  v_pk_add_f32 v[208:209], v[208:209], v[56:57] neg_lo:[0,1] neg_hi:[0,1]
  v_pk_add_f32 v[210:211], v[210:211], v[58:59] neg_lo:[0,1] neg_hi:[0,1]
  v_cvt_pk_bf16_f32 v158, v208, v209
  v_cvt_pk_bf16_f32 v159, v210, v211
  v_lshlrev_b32 v208, 16, v158
  v_and_b32 v209, 0xffff0000, v158
  v_lshlrev_b32 v210, 16, v159
  v_and_b32 v211, 0xffff0000, v159
  v_pk_mul_f32 v[208:209], v[208:209], v[16:17]
  v_pk_mul_f32 v[210:211], v[210:211], v[18:19]
  v_cvt_pk_bf16_f32 v100, v208, v209
  v_cvt_pk_bf16_f32 v101, v210, v211
  v_cvt_f32_i32 v212, v212
  v_cvt_f32_i32 v213, v213
  v_cvt_f32_i32 v214, v214
  v_cvt_f32_i32 v215, v215
  v_pk_add_f32 v[212:213], v[212:213], v[60:61] neg_lo:[0,1] neg_hi:[0,1]
  v_pk_add_f32 v[214:215], v[214:215], v[62:63] neg_lo:[0,1] neg_hi:[0,1]
  v_cvt_pk_bf16_f32 v158, v212, v213
  v_cvt_pk_bf16_f32 v159, v214, v215
  v_lshlrev_b32 v212, 16, v158
  v_and_b32 v213, 0xffff0000, v158
  v_lshlrev_b32 v214, 16, v159
  v_and_b32 v215, 0xffff0000, v159
  v_pk_mul_f32 v[212:213], v[212:213], v[20:21]
  v_pk_mul_f32 v[214:215], v[214:215], v[22:23]
  v_cvt_pk_bf16_f32 v102, v212, v213
  v_cvt_pk_bf16_f32 v103, v214, v215
  s_nop 1
  v_mfma_f32_16x16x32_bf16 v[112:115], v[100:103], v[32:35], 0
  v_cvt_f32_i32 v216, v216
  v_cvt_f32_i32 v217, v217
  v_cvt_f32_i32 v218, v218
  v_cvt_f32_i32 v219, v219
  v_pk_add_f32 v[216:217], v[216:217], v[64:65] neg_lo:[0,1] neg_hi:[0,1]
  v_pk_add_f32 v[218:219], v[218:219], v[66:67] neg_lo:[0,1] neg_hi:[0,1]
  v_cvt_pk_bf16_f32 v158, v216, v217
  v_cvt_pk_bf16_f32 v159, v218, v219
  buffer_load_dwordx4 v[160:163], v132, s[32:35], s4 offen nt
  buffer_load_dwordx4 v[164:167], v133, s[32:35], s4 offen nt
  buffer_load_dwordx4 v[168:171], v134, s[32:35], s4 offen nt
  buffer_load_dwordx4 v[172:175], v135, s[32:35], s4 offen nt
  s_add_u32 s4, s4, 4096
  buffer_load_dwordx4 v[176:179], v132, s[32:35], s4 offen nt
  buffer_load_dwordx4 v[180:183], v133, s[32:35], s4 offen nt
  buffer_load_dwordx4 v[184:187], v134, s[32:35], s4 offen nt
  buffer_load_dwordx4 v[188:191], v135, s[32:35], s4 offen nt
  s_add_u32 s4, s4, 28672
  v_lshlrev_b32 v216, 16, v158
  v_and_b32 v217, 0xffff0000, v158
  v_lshlrev_b32 v218, 16, v159
  v_and_b32 v219, 0xffff0000, v159
  v_pk_mul_f32 v[216:217], v[216:217], v[24:25]
  v_pk_mul_f32 v[218:219], v[218:219], v[26:27]
  v_cvt_pk_bf16_f32 v104, v216, v217
  v_cvt_pk_bf16_f32 v105, v218, v219
  v_cvt_f32_i32 v220, v220
  v_cvt_f32_i32 v221, v221
  v_cvt_f32_i32 v222, v222
  v_cvt_f32_i32 v223, v223
  v_pk_add_f32 v[220:221], v[220:221], v[68:69] neg_lo:[0,1] neg_hi:[0,1]
  v_pk_add_f32 v[222:223], v[222:223], v[70:71] neg_lo:[0,1] neg_hi:[0,1]
  v_cvt_pk_bf16_f32 v158, v220, v221
  v_cvt_pk_bf16_f32 v159, v222, v223
  v_lshlrev_b32 v220, 16, v158
  v_and_b32 v221, 0xffff0000, v158
  v_lshlrev_b32 v222, 16, v159
  v_and_b32 v223, 0xffff0000, v159
  v_pk_mul_f32 v[220:221], v[220:221], v[28:29]
  v_pk_mul_f32 v[222:223], v[222:223], v[30:31]
  v_cvt_pk_bf16_f32 v106, v220, v221
  v_cvt_pk_bf16_f32 v107, v222, v223
  s_nop 1
  v_mfma_f32_16x16x32_bf16 v[112:115], v[104:107], v[36:39], v[112:115]
  v_add_f32_dpp v100, v109, v108 row_ror:8 row_mask:0xf bank_mask:0x3
  v_add_f32_dpp v100, v108, v109 row_ror:8 row_mask:0xf bank_mask:0xc
  v_add_f32_dpp v101, v111, v110 row_ror:8 row_mask:0xf bank_mask:0x3
  v_add_f32_dpp v101, v110, v111 row_ror:8 row_mask:0xf bank_mask:0xc
  s_nop 3
  v_add_f32_dpp v102, v113, v112 row_ror:8 row_mask:0xf bank_mask:0x3
  v_add_f32_dpp v102, v112, v113 row_ror:8 row_mask:0xf bank_mask:0xc
  v_add_f32_dpp v103, v115, v114 row_ror:8 row_mask:0xf bank_mask:0x3
  v_add_f32_dpp v103, v114, v115 row_ror:8 row_mask:0xf bank_mask:0xc
  v_cvt_pk_bf16_f32 v158, v100, v101
  v_cvt_pk_bf16_f32 v159, v102, v103
  v_lshlrev_b32 v100, 16, v158
  v_and_b32 v101, 0xffff0000, v158
  v_lshlrev_b32 v102, 16, v159
  v_and_b32 v103, 0xffff0000, v159
  v_pk_mul_f32 v[100:101], v[100:101], s[38:39]
  v_pk_mul_f32 v[102:103], v[102:103], s[38:39]
  v_cvt_pk_bf16_f32 v112, v100, v101
  v_cvt_pk_bf16_f32 v113, v102, v103
  v_lshlrev_b32 v100, 16, v112
  v_and_b32 v101, 0xffff0000, v112
  v_lshlrev_b32 v102, 16, v113
  v_and_b32 v103, 0xffff0000, v113
  ds_write_b64 v2, v[112:113]
  v_max3_f32 v11, v100, v101, v102
  v_max3_f32 v11, v11, v103, v9
  v_mov_b32 v13, v11
  v_mov_b32 v15, v14
  v_add_u32 v2, 256, v2
  v_permlane32_swap_b32 v11, v13
  v_max_f32 v11, v11, v13
  v_mov_b32 v13, v11
  s_nop 1
  v_permlane16_swap_b32 v11, v13
  v_max_f32 v9, v11, v13
  v_mul_f32 v14, s8, v9
  v_sub_f32 v12, v14, v15
  v_exp_f32 v12, v12
  v_fma_f32 v104, v100, s7, v14
  v_fma_f32 v105, v101, s7, v14
  v_fma_f32 v106, v102, s7, v14
  v_fma_f32 v107, v103, s7, v14
  v_exp_f32 v104, v104
  v_exp_f32 v105, v105
  v_exp_f32 v106, v106
  v_exp_f32 v107, v107
  v_add_f32 v11, v104, v105
  v_add_f32 v13, v106, v107
  v_add_f32 v11, v11, v13
  v_fma_f32 v10, v10, v12, v11
  s_add_u32 s6, s6, 1
  s_cmp_lt_u32 s6, 32
  s_cbranch_scc1 L_k
  v_mov_b32 v13, v10
  ds_write_b32 v148, v14 offset:256
  s_nop 0
  v_permlane32_swap_b32 v10, v13
  v_add_f32 v10, v10, v13
  v_mov_b32 v13, v10
  s_nop 1
  v_permlane16_swap_b32 v10, v13
  v_add_f32 v13, v10, v13
  ds_write_b32 v148, v13 offset:384
  s_mov_b64 exec, 1
  ds_add_u32 v153, v139 offset:4
  s_mov_b64 exec, -1
  v_subrev_u32 v2, 16384, v2
  s_mov_b32 s64, 0
  s_mov_b32 s66, -1
  ds_read_b64 v[156:157], v2
  ds_read2_b32 v[88:89], v6 offset0:0 offset1:4
  ds_read_b32 v90, v6 offset:8192
  ds_read_b32 v91, v6 offset:8208
  v_add_u32 v6, 128, v6
  v_add_u32 v2, 256, v2
L_vpair:
L_ws:
  ds_read_b32 v154, v155 offset:0
  s_waitcnt lgkmcnt(0)
  v_readfirstlane_b32 s12, v154
  s_nop 1
  s_cmp_lt_u32 s12, 4
  s_cbranch_scc1 L_ws
  v_add_u32 v155, 4, v155
  ds_read_b128 v[40:43], v149
  ds_read_b128 v[44:47], v149 offset:128
  v_add_u32 v149, 256, v149
  v_mov_b32 v116, 0
  v_mov_b32 v117, 0
  v_mov_b32 v118, 0
  v_mov_b32 v119, 0
  v_mov_b32 v120, 0
  v_mov_b32 v121, 0
  v_mov_b32 v122, 0
  v_mov_b32 v123, 0
  v_mov_b32 v124, 0
  v_mov_b32 v125, 0
  v_mov_b32 v126, 0
  v_mov_b32 v127, 0
  v_mov_b32 v128, 0
  v_mov_b32 v129, 0
  v_mov_b32 v130, 0
  v_mov_b32 v131, 0
  s_waitcnt lgkmcnt(0)
  v_min3_f32 v14, v40, v41, v42
  v_min_f32 v14, v14, v43
  v_sub_f32 v40, v14, v40
  v_sub_f32 v41, v14, v41
  v_sub_f32 v42, v14, v42
  v_sub_f32 v43, v14, v43
  v_exp_f32 v40, v40
  v_exp_f32 v41, v41
  v_exp_f32 v42, v42
  v_exp_f32 v43, v43
  v_mul_f32 v11, v40, v44
  v_fma_f32 v11, v41, v45, v11
  v_fma_f32 v11, v42, v46, v11
  v_fma_f32 v11, v43, v47, v11
  v_rcp_f32 v12, v11
  s_mov_b32 s6, 16
  s_nop 0
L_v:
  s_cmp_lg_u32 s6, s66
  s_cbranch_scc1 L_v1
L_wf:
  ds_read_b32 v154, v153 offset:8
  s_waitcnt lgkmcnt(0)
  v_readfirstlane_b32 s12, v154
  s_nop 1
  s_cmp_lt_u32 s12, 4
  s_cbranch_scc1 L_wf
  ds_read_b128 v[56:59], v151 offset:0
  ds_read_b128 v[60:63], v151 offset:4224
  ds_read_b128 v[64:67], v151 offset:8448
  ds_read_b128 v[68:71], v151 offset:12672
  s_waitcnt lgkmcnt(2)
  v_pk_add_f32 v[56:57], v[56:57], v[60:61]
  v_pk_add_f32 v[58:59], v[58:59], v[62:63]
  s_waitcnt lgkmcnt(0)
  v_pk_add_f32 v[64:65], v[64:65], v[68:69]
  v_pk_add_f32 v[66:67], v[66:67], v[70:71]
  v_pk_add_f32 v[56:57], v[56:57], v[64:65]
  v_pk_add_f32 v[58:59], v[58:59], v[66:67]
  v_cvt_pk_bf16_f32 v32, v56, v57
  v_cvt_pk_bf16_f32 v33, v58, v59
  buffer_store_dwordx2 v[32:33], v152, s[60:63], 0 offen offset:0
  s_nop 0
L_v1:
  s_waitcnt lgkmcnt(0)
  v_lshlrev_b32 v104, 16, v156
  v_and_b32 v105, 0xffff0000, v156
  v_lshlrev_b32 v106, 16, v157
  v_and_b32 v107, 0xffff0000, v157
  v_lshlrev_b32 v92, 16, v88
  v_and_b32 v93, 0xffff0000, v88
  v_lshlrev_b32 v96, 16, v90
  v_and_b32 v97, 0xffff0000, v90
  v_lshlrev_b32 v94, 16, v89
  v_and_b32 v95, 0xffff0000, v89
  v_lshlrev_b32 v98, 16, v91
  v_and_b32 v99, 0xffff0000, v91
  ds_read_b64 v[156:157], v2
  ds_read2_b32 v[88:89], v6 offset0:0 offset1:4
  ds_read_b32 v90, v6 offset:8192
  ds_read_b32 v91, v6 offset:8208
  v_add_u32 v6, 128, v6
  v_add_u32 v2, 256, v2
  v_fma_f32 v104, v104, s7, v14
  v_fma_f32 v105, v105, s7, v14
  v_fma_f32 v106, v106, s7, v14
  v_fma_f32 v107, v107, s7, v14
  v_exp_f32 v104, v104
  v_exp_f32 v105, v105
  v_exp_f32 v106, v106
  v_exp_f32 v107, v107
  v_pk_mul_f32 v[104:105], v[104:105], v[12:13] op_sel_hi:[1,0]
  v_pk_mul_f32 v[106:107], v[106:107], v[12:13] op_sel_hi:[1,0]
  v_cvt_pk_bf16_f32 v112, v104, v105
  v_cvt_pk_bf16_f32 v113, v106, v107
  v_and_b32 v108, v112, v7
  v_and_b32 v109, v113, v7
  v_and_b32 v110, v112, v8
  v_and_b32 v111, v113, v8
  s_waitcnt vmcnt(0)
  v_cvt_f32_i32 v160, v160
  v_cvt_f32_i32 v161, v161
  v_cvt_f32_i32 v162, v162
  v_cvt_f32_i32 v163, v163
  v_pk_add_f32 v[160:161], v[160:161], v[96:97] op_sel_hi:[1,0] neg_lo:[0,1] neg_hi:[0,1]
  v_pk_add_f32 v[162:163], v[162:163], v[96:97] op_sel_hi:[1,0] neg_lo:[0,1] neg_hi:[0,1]
  v_cvt_pk_bf16_f32 v158, v160, v161
  v_cvt_pk_bf16_f32 v159, v162, v163
  v_lshlrev_b32 v160, 16, v158
  v_and_b32 v161, 0xffff0000, v158
  v_lshlrev_b32 v162, 16, v159
  v_and_b32 v163, 0xffff0000, v159
  v_pk_mul_f32 v[160:161], v[160:161], v[92:93] op_sel_hi:[1,0]
  v_pk_mul_f32 v[162:163], v[162:163], v[92:93] op_sel_hi:[1,0]
  v_cvt_f32_i32 v164, v164
  v_cvt_f32_i32 v165, v165
  v_cvt_f32_i32 v166, v166
  v_cvt_f32_i32 v167, v167
  v_pk_add_f32 v[164:165], v[164:165], v[96:97] op_sel:[0,1] op_sel_hi:[1,1] neg_lo:[0,1] neg_hi:[0,1]
  v_pk_add_f32 v[166:167], v[166:167], v[96:97] op_sel:[0,1] op_sel_hi:[1,1] neg_lo:[0,1] neg_hi:[0,1]
  v_cvt_pk_bf16_f32 v158, v164, v165
  v_cvt_pk_bf16_f32 v159, v166, v167
  v_lshlrev_b32 v164, 16, v158
  v_and_b32 v165, 0xffff0000, v158
  v_lshlrev_b32 v166, 16, v159
  v_and_b32 v167, 0xffff0000, v159
  v_pk_mul_f32 v[164:165], v[164:165], v[92:93] op_sel:[0,1] op_sel_hi:[1,1]
  v_pk_mul_f32 v[166:167], v[166:167], v[92:93] op_sel:[0,1] op_sel_hi:[1,1]
  v_cvt_pk_bf16_f32 v72, v160, v164
  v_cvt_pk_bf16_f32 v76, v161, v165
  v_cvt_pk_bf16_f32 v80, v162, v166
  v_cvt_pk_bf16_f32 v84, v163, v167
  v_cvt_f32_i32 v168, v168
  v_cvt_f32_i32 v169, v169
  v_cvt_f32_i32 v170, v170
  v_cvt_f32_i32 v171, v171
  v_pk_add_f32 v[168:169], v[168:169], v[96:97] op_sel_hi:[1,0] neg_lo:[0,1] neg_hi:[0,1]
  v_pk_add_f32 v[170:171], v[170:171], v[96:97] op_sel_hi:[1,0] neg_lo:[0,1] neg_hi:[0,1]
  v_cvt_pk_bf16_f32 v158, v168, v169
  v_cvt_pk_bf16_f32 v159, v170, v171
  v_lshlrev_b32 v168, 16, v158
  v_and_b32 v169, 0xffff0000, v158
  v_lshlrev_b32 v170, 16, v159
  v_and_b32 v171, 0xffff0000, v159
  v_pk_mul_f32 v[168:169], v[168:169], v[92:93] op_sel_hi:[1,0]
  v_pk_mul_f32 v[170:171], v[170:171], v[92:93] op_sel_hi:[1,0]
  v_cvt_f32_i32 v172, v172
  v_cvt_f32_i32 v173, v173
  v_cvt_f32_i32 v174, v174
  v_cvt_f32_i32 v175, v175
  v_pk_add_f32 v[172:173], v[172:173], v[96:97] op_sel:[0,1] op_sel_hi:[1,1] neg_lo:[0,1] neg_hi:[0,1]
  v_pk_add_f32 v[174:175], v[174:175], v[96:97] op_sel:[0,1] op_sel_hi:[1,1] neg_lo:[0,1] neg_hi:[0,1]
  v_cvt_pk_bf16_f32 v158, v172, v173
  v_cvt_pk_bf16_f32 v159, v174, v175
  v_lshlrev_b32 v172, 16, v158
  v_and_b32 v173, 0xffff0000, v158
  v_lshlrev_b32 v174, 16, v159
  v_and_b32 v175, 0xffff0000, v159
  v_pk_mul_f32 v[172:173], v[172:173], v[92:93] op_sel:[0,1] op_sel_hi:[1,1]
  v_pk_mul_f32 v[174:175], v[174:175], v[92:93] op_sel:[0,1] op_sel_hi:[1,1]
  v_cvt_pk_bf16_f32 v74, v168, v172
  v_cvt_pk_bf16_f32 v78, v169, v173
  v_cvt_pk_bf16_f32 v82, v170, v174
  v_cvt_pk_bf16_f32 v86, v171, v175
  v_cvt_f32_i32 v176, v176
  v_cvt_f32_i32 v177, v177
  v_cvt_f32_i32 v178, v178
  v_cvt_f32_i32 v179, v179
  v_pk_add_f32 v[176:177], v[176:177], v[98:99] op_sel_hi:[1,0] neg_lo:[0,1] neg_hi:[0,1]
  v_pk_add_f32 v[178:179], v[178:179], v[98:99] op_sel_hi:[1,0] neg_lo:[0,1] neg_hi:[0,1]
  v_cvt_pk_bf16_f32 v158, v176, v177
  v_cvt_pk_bf16_f32 v159, v178, v179
  v_lshlrev_b32 v176, 16, v158
  v_and_b32 v177, 0xffff0000, v158
  v_lshlrev_b32 v178, 16, v159
  v_and_b32 v179, 0xffff0000, v159
  v_pk_mul_f32 v[176:177], v[176:177], v[94:95] op_sel_hi:[1,0]
  v_pk_mul_f32 v[178:179], v[178:179], v[94:95] op_sel_hi:[1,0]
  v_cvt_f32_i32 v180, v180
  v_cvt_f32_i32 v181, v181
  v_cvt_f32_i32 v182, v182
  v_cvt_f32_i32 v183, v183
  v_pk_add_f32 v[180:181], v[180:181], v[98:99] op_sel:[0,1] op_sel_hi:[1,1] neg_lo:[0,1] neg_hi:[0,1]
  v_pk_add_f32 v[182:183], v[182:183], v[98:99] op_sel:[0,1] op_sel_hi:[1,1] neg_lo:[0,1] neg_hi:[0,1]
  v_cvt_pk_bf16_f32 v158, v180, v181
  v_cvt_pk_bf16_f32 v159, v182, v183
  v_lshlrev_b32 v180, 16, v158
  v_and_b32 v181, 0xffff0000, v158
  v_lshlrev_b32 v182, 16, v159
  v_and_b32 v183, 0xffff0000, v159
  v_pk_mul_f32 v[180:181], v[180:181], v[94:95] op_sel:[0,1] op_sel_hi:[1,1]
  v_pk_mul_f32 v[182:183], v[182:183], v[94:95] op_sel:[0,1] op_sel_hi:[1,1]
  v_cvt_pk_bf16_f32 v73, v176, v180
  v_cvt_pk_bf16_f32 v77, v177, v181
  v_cvt_pk_bf16_f32 v81, v178, v182
  v_cvt_pk_bf16_f32 v85, v179, v183
  v_cvt_f32_i32 v184, v184
  v_cvt_f32_i32 v185, v185
  v_cvt_f32_i32 v186, v186
  v_cvt_f32_i32 v187, v187
  v_pk_add_f32 v[184:185], v[184:185], v[98:99] op_sel_hi:[1,0] neg_lo:[0,1] neg_hi:[0,1]
  v_pk_add_f32 v[186:187], v[186:187], v[98:99] op_sel_hi:[1,0] neg_lo:[0,1] neg_hi:[0,1]
  v_cvt_pk_bf16_f32 v158, v184, v185
  v_cvt_pk_bf16_f32 v159, v186, v187
  buffer_load_dwordx4 v[192:195], v132, s[32:35], s4 offen nt
  buffer_load_dwordx4 v[196:199], v133, s[32:35], s4 offen nt
  buffer_load_dwordx4 v[200:203], v134, s[32:35], s4 offen nt
  buffer_load_dwordx4 v[204:207], v135, s[32:35], s4 offen nt
  s_add_u32 s4, s4, 4096
  buffer_load_dwordx4 v[208:211], v132, s[32:35], s4 offen nt
  buffer_load_dwordx4 v[212:215], v133, s[32:35], s4 offen nt
  buffer_load_dwordx4 v[216:219], v134, s[32:35], s4 offen nt
  buffer_load_dwordx4 v[220:223], v135, s[32:35], s4 offen nt
  s_add_u32 s4, s4, 28672
  v_lshlrev_b32 v184, 16, v158
  v_and_b32 v185, 0xffff0000, v158
  v_lshlrev_b32 v186, 16, v159
  v_and_b32 v187, 0xffff0000, v159
  v_pk_mul_f32 v[184:185], v[184:185], v[94:95] op_sel_hi:[1,0]
  v_pk_mul_f32 v[186:187], v[186:187], v[94:95] op_sel_hi:[1,0]
  v_cvt_f32_i32 v188, v188
  v_cvt_f32_i32 v189, v189
  v_cvt_f32_i32 v190, v190
  v_cvt_f32_i32 v191, v191
  v_pk_add_f32 v[188:189], v[188:189], v[98:99] op_sel:[0,1] op_sel_hi:[1,1] neg_lo:[0,1] neg_hi:[0,1]
  v_pk_add_f32 v[190:191], v[190:191], v[98:99] op_sel:[0,1] op_sel_hi:[1,1] neg_lo:[0,1] neg_hi:[0,1]
  v_cvt_pk_bf16_f32 v158, v188, v189
  v_cvt_pk_bf16_f32 v159, v190, v191
  v_lshlrev_b32 v188, 16, v158
  v_and_b32 v189, 0xffff0000, v158
  v_lshlrev_b32 v190, 16, v159
  v_and_b32 v191, 0xffff0000, v159
  v_pk_mul_f32 v[188:189], v[188:189], v[94:95] op_sel:[0,1] op_sel_hi:[1,1]
  v_pk_mul_f32 v[190:191], v[190:191], v[94:95] op_sel:[0,1] op_sel_hi:[1,1]
  v_cvt_pk_bf16_f32 v75, v184, v188
  v_cvt_pk_bf16_f32 v79, v185, v189
  v_cvt_pk_bf16_f32 v83, v186, v190
  v_cvt_pk_bf16_f32 v87, v187, v191
  v_mfma_f32_16x16x32_bf16 v[116:119], v[72:75], v[108:111], v[116:119]
  v_mfma_f32_16x16x32_bf16 v[120:123], v[76:79], v[108:111], v[120:123]
  v_mfma_f32_16x16x32_bf16 v[124:127], v[80:83], v[108:111], v[124:127]
  v_mfma_f32_16x16x32_bf16 v[128:131], v[84:87], v[108:111], v[128:131]
  s_waitcnt lgkmcnt(0)
  v_lshlrev_b32 v104, 16, v156
  v_and_b32 v105, 0xffff0000, v156
  v_lshlrev_b32 v106, 16, v157
  v_and_b32 v107, 0xffff0000, v157
  v_lshlrev_b32 v92, 16, v88
  v_and_b32 v93, 0xffff0000, v88
  v_lshlrev_b32 v96, 16, v90
  v_and_b32 v97, 0xffff0000, v90
  v_lshlrev_b32 v94, 16, v89
  v_and_b32 v95, 0xffff0000, v89
  v_lshlrev_b32 v98, 16, v91
  v_and_b32 v99, 0xffff0000, v91
  ds_read_b64 v[156:157], v2
  ds_read2_b32 v[88:89], v6 offset0:0 offset1:4
  ds_read_b32 v90, v6 offset:8192
  ds_read_b32 v91, v6 offset:8208
  v_add_u32 v6, 128, v6
  v_add_u32 v2, 256, v2
  v_fma_f32 v104, v104, s7, v14
  v_fma_f32 v105, v105, s7, v14
  v_fma_f32 v106, v106, s7, v14
  v_fma_f32 v107, v107, s7, v14
  v_exp_f32 v104, v104
  v_exp_f32 v105, v105
  v_exp_f32 v106, v106
  v_exp_f32 v107, v107
  v_pk_mul_f32 v[104:105], v[104:105], v[12:13] op_sel_hi:[1,0]
  v_pk_mul_f32 v[106:107], v[106:107], v[12:13] op_sel_hi:[1,0]
  v_cvt_pk_bf16_f32 v112, v104, v105
  v_cvt_pk_bf16_f32 v113, v106, v107
  v_and_b32 v108, v112, v7
  v_and_b32 v109, v113, v7
  v_and_b32 v110, v112, v8
  v_and_b32 v111, v113, v8
  s_waitcnt vmcnt(0)
  v_cvt_f32_i32 v192, v192
  v_cvt_f32_i32 v193, v193
  v_cvt_f32_i32 v194, v194
  v_cvt_f32_i32 v195, v195
  v_pk_add_f32 v[192:193], v[192:193], v[96:97] op_sel_hi:[1,0] neg_lo:[0,1] neg_hi:[0,1]
  v_pk_add_f32 v[194:195], v[194:195], v[96:97] op_sel_hi:[1,0] neg_lo:[0,1] neg_hi:[0,1]
  v_cvt_pk_bf16_f32 v158, v192, v193
  v_cvt_pk_bf16_f32 v159, v194, v195
  v_lshlrev_b32 v192, 16, v158
  v_and_b32 v193, 0xffff0000, v158
  v_lshlrev_b32 v194, 16, v159
  v_and_b32 v195, 0xffff0000, v159
  v_pk_mul_f32 v[192:193], v[192:193], v[92:93] op_sel_hi:[1,0]
  v_pk_mul_f32 v[194:195], v[194:195], v[92:93] op_sel_hi:[1,0]
  v_cvt_f32_i32 v196, v196
  v_cvt_f32_i32 v197, v197
  v_cvt_f32_i32 v198, v198
  v_cvt_f32_i32 v199, v199
  v_pk_add_f32 v[196:197], v[196:197], v[96:97] op_sel:[0,1] op_sel_hi:[1,1] neg_lo:[0,1] neg_hi:[0,1]
  v_pk_add_f32 v[198:199], v[198:199], v[96:97] op_sel:[0,1] op_sel_hi:[1,1] neg_lo:[0,1] neg_hi:[0,1]
  v_cvt_pk_bf16_f32 v158, v196, v197
  v_cvt_pk_bf16_f32 v159, v198, v199
  v_lshlrev_b32 v196, 16, v158
  v_and_b32 v197, 0xffff0000, v158
  v_lshlrev_b32 v198, 16, v159
  v_and_b32 v199, 0xffff0000, v159
  v_pk_mul_f32 v[196:197], v[196:197], v[92:93] op_sel:[0,1] op_sel_hi:[1,1]
  v_pk_mul_f32 v[198:199], v[198:199], v[92:93] op_sel:[0,1] op_sel_hi:[1,1]
  v_cvt_pk_bf16_f32 v72, v192, v196
  v_cvt_pk_bf16_f32 v76, v193, v197
  v_cvt_pk_bf16_f32 v80, v194, v198
  v_cvt_pk_bf16_f32 v84, v195, v199
  v_cvt_f32_i32 v200, v200
  v_cvt_f32_i32 v201, v201
  v_cvt_f32_i32 v202, v202
  v_cvt_f32_i32 v203, v203
  v_pk_add_f32 v[200:201], v[200:201], v[96:97] op_sel_hi:[1,0] neg_lo:[0,1] neg_hi:[0,1]
  v_pk_add_f32 v[202:203], v[202:203], v[96:97] op_sel_hi:[1,0] neg_lo:[0,1] neg_hi:[0,1]
  v_cvt_pk_bf16_f32 v158, v200, v201
  v_cvt_pk_bf16_f32 v159, v202, v203
  v_lshlrev_b32 v200, 16, v158
  v_and_b32 v201, 0xffff0000, v158
  v_lshlrev_b32 v202, 16, v159
  v_and_b32 v203, 0xffff0000, v159
  v_pk_mul_f32 v[200:201], v[200:201], v[92:93] op_sel_hi:[1,0]
  v_pk_mul_f32 v[202:203], v[202:203], v[92:93] op_sel_hi:[1,0]
  v_cvt_f32_i32 v204, v204
  v_cvt_f32_i32 v205, v205
  v_cvt_f32_i32 v206, v206
  v_cvt_f32_i32 v207, v207
  v_pk_add_f32 v[204:205], v[204:205], v[96:97] op_sel:[0,1] op_sel_hi:[1,1] neg_lo:[0,1] neg_hi:[0,1]
  v_pk_add_f32 v[206:207], v[206:207], v[96:97] op_sel:[0,1] op_sel_hi:[1,1] neg_lo:[0,1] neg_hi:[0,1]
  v_cvt_pk_bf16_f32 v158, v204, v205
  v_cvt_pk_bf16_f32 v159, v206, v207
  v_lshlrev_b32 v204, 16, v158
  v_and_b32 v205, 0xffff0000, v158
  v_lshlrev_b32 v206, 16, v159
  v_and_b32 v207, 0xffff0000, v159
  v_pk_mul_f32 v[204:205], v[204:205], v[92:93] op_sel:[0,1] op_sel_hi:[1,1]
  v_pk_mul_f32 v[206:207], v[206:207], v[92:93] op_sel:[0,1] op_sel_hi:[1,1]
  v_cvt_pk_bf16_f32 v74, v200, v204
  v_cvt_pk_bf16_f32 v78, v201, v205
  v_cvt_pk_bf16_f32 v82, v202, v206
  v_cvt_pk_bf16_f32 v86, v203, v207
  v_cvt_f32_i32 v208, v208
  v_cvt_f32_i32 v209, v209
  v_cvt_f32_i32 v210, v210
  v_cvt_f32_i32 v211, v211
  v_pk_add_f32 v[208:209], v[208:209], v[98:99] op_sel_hi:[1,0] neg_lo:[0,1] neg_hi:[0,1]
  v_pk_add_f32 v[210:211], v[210:211], v[98:99] op_sel_hi:[1,0] neg_lo:[0,1] neg_hi:[0,1]
  v_cvt_pk_bf16_f32 v158, v208, v209
  v_cvt_pk_bf16_f32 v159, v210, v211
  v_lshlrev_b32 v208, 16, v158
  v_and_b32 v209, 0xffff0000, v158
  v_lshlrev_b32 v210, 16, v159
  v_and_b32 v211, 0xffff0000, v159
  v_pk_mul_f32 v[208:209], v[208:209], v[94:95] op_sel_hi:[1,0]
  v_pk_mul_f32 v[210:211], v[210:211], v[94:95] op_sel_hi:[1,0]
  v_cvt_f32_i32 v212, v212
  v_cvt_f32_i32 v213, v213
  v_cvt_f32_i32 v214, v214
  v_cvt_f32_i32 v215, v215
  v_pk_add_f32 v[212:213], v[212:213], v[98:99] op_sel:[0,1] op_sel_hi:[1,1] neg_lo:[0,1] neg_hi:[0,1]
  v_pk_add_f32 v[214:215], v[214:215], v[98:99] op_sel:[0,1] op_sel_hi:[1,1] neg_lo:[0,1] neg_hi:[0,1]
  v_cvt_pk_bf16_f32 v158, v212, v213
  v_cvt_pk_bf16_f32 v159, v214, v215
  v_lshlrev_b32 v212, 16, v158
  v_and_b32 v213, 0xffff0000, v158
  v_lshlrev_b32 v214, 16, v159
  v_and_b32 v215, 0xffff0000, v159
  v_pk_mul_f32 v[212:213], v[212:213], v[94:95] op_sel:[0,1] op_sel_hi:[1,1]
  v_pk_mul_f32 v[214:215], v[214:215], v[94:95] op_sel:[0,1] op_sel_hi:[1,1]
  v_cvt_pk_bf16_f32 v73, v208, v212
  v_cvt_pk_bf16_f32 v77, v209, v213
  v_cvt_pk_bf16_f32 v81, v210, v214
  v_cvt_pk_bf16_f32 v85, v211, v215
  v_cvt_f32_i32 v216, v216
  v_cvt_f32_i32 v217, v217
  v_cvt_f32_i32 v218, v218
  v_cvt_f32_i32 v219, v219
  v_pk_add_f32 v[216:217], v[216:217], v[98:99] op_sel_hi:[1,0] neg_lo:[0,1] neg_hi:[0,1]
  v_pk_add_f32 v[218:219], v[218:219], v[98:99] op_sel_hi:[1,0] neg_lo:[0,1] neg_hi:[0,1]
  v_cvt_pk_bf16_f32 v158, v216, v217
  v_cvt_pk_bf16_f32 v159, v218, v219
  buffer_load_dwordx4 v[160:163], v132, s[32:35], s4 offen nt
  buffer_load_dwordx4 v[164:167], v133, s[32:35], s4 offen nt
  buffer_load_dwordx4 v[168:171], v134, s[32:35], s4 offen nt
  buffer_load_dwordx4 v[172:175], v135, s[32:35], s4 offen nt
  s_add_u32 s4, s4, 4096
  buffer_load_dwordx4 v[176:179], v132, s[32:35], s4 offen nt
  buffer_load_dwordx4 v[180:183], v133, s[32:35], s4 offen nt
  buffer_load_dwordx4 v[184:187], v134, s[32:35], s4 offen nt
  buffer_load_dwordx4 v[188:191], v135, s[32:35], s4 offen nt
  s_add_u32 s4, s4, 28672
  v_lshlrev_b32 v216, 16, v158
  v_and_b32 v217, 0xffff0000, v158
  v_lshlrev_b32 v218, 16, v159
  v_and_b32 v219, 0xffff0000, v159
  v_pk_mul_f32 v[216:217], v[216:217], v[94:95] op_sel_hi:[1,0]
  v_pk_mul_f32 v[218:219], v[218:219], v[94:95] op_sel_hi:[1,0]
  v_cvt_f32_i32 v220, v220
  v_cvt_f32_i32 v221, v221
  v_cvt_f32_i32 v222, v222
  v_cvt_f32_i32 v223, v223
  v_pk_add_f32 v[220:221], v[220:221], v[98:99] op_sel:[0,1] op_sel_hi:[1,1] neg_lo:[0,1] neg_hi:[0,1]
  v_pk_add_f32 v[222:223], v[222:223], v[98:99] op_sel:[0,1] op_sel_hi:[1,1] neg_lo:[0,1] neg_hi:[0,1]
  v_cvt_pk_bf16_f32 v158, v220, v221
  v_cvt_pk_bf16_f32 v159, v222, v223
  v_lshlrev_b32 v220, 16, v158
  v_and_b32 v221, 0xffff0000, v158
  v_lshlrev_b32 v222, 16, v159
  v_and_b32 v223, 0xffff0000, v159
  v_pk_mul_f32 v[220:221], v[220:221], v[94:95] op_sel:[0,1] op_sel_hi:[1,1]
  v_pk_mul_f32 v[222:223], v[222:223], v[94:95] op_sel:[0,1] op_sel_hi:[1,1]
  v_cvt_pk_bf16_f32 v75, v216, v220
  v_cvt_pk_bf16_f32 v79, v217, v221
  v_cvt_pk_bf16_f32 v83, v218, v222
  v_cvt_pk_bf16_f32 v87, v219, v223
  v_mfma_f32_16x16x32_bf16 v[116:119], v[72:75], v[108:111], v[116:119]
  v_mfma_f32_16x16x32_bf16 v[120:123], v[76:79], v[108:111], v[120:123]
  v_mfma_f32_16x16x32_bf16 v[124:127], v[80:83], v[108:111], v[124:127]
  v_mfma_f32_16x16x32_bf16 v[128:131], v[84:87], v[108:111], v[128:131]
  s_sub_u32 s6, s6, 1
  s_cmp_lg_u32 s6, 0
  s_cbranch_scc1 L_v
  s_nop 1
  v_mov_b32 v56, v116
  v_mov_b32 v57, v120
  v_mov_b32 v58, v124
  v_mov_b32 v59, v128
  ds_write_b128 v150, v[56:59] offset:0
  v_mov_b32 v60, v117
  v_mov_b32 v61, v121
  v_mov_b32 v62, v125
  v_mov_b32 v63, v129
  ds_write_b128 v150, v[60:63] offset:16
  v_mov_b32 v64, v118
  v_mov_b32 v65, v122
  v_mov_b32 v66, v126
  v_mov_b32 v67, v130
  ds_write_b128 v150, v[64:67] offset:32
  v_mov_b32 v68, v119
  v_mov_b32 v69, v123
  v_mov_b32 v70, v127
  v_mov_b32 v71, v131
  ds_write_b128 v150, v[68:71] offset:48
  s_cmp_lg_u32 s64, 0
  s_cbranch_scc1 L_fin
  v_add_u32 v150, 16896, v150
  s_mov_b32 s64, 1
  s_mov_b64 exec, 1
  ds_add_u32 v153, v139 offset:8
  s_mov_b64 exec, -1
  s_mov_b32 s66, 13
  s_branch L_vpair
L_fin:
  s_waitcnt lgkmcnt(0)
  s_barrier
  ds_read_b128 v[56:59], v151 offset:16896
  ds_read_b128 v[60:63], v151 offset:21120
  ds_read_b128 v[64:67], v151 offset:25344
  ds_read_b128 v[68:71], v151 offset:29568
  s_waitcnt lgkmcnt(2)
  v_pk_add_f32 v[56:57], v[56:57], v[60:61]
  v_pk_add_f32 v[58:59], v[58:59], v[62:63]
  s_waitcnt lgkmcnt(0)
  v_pk_add_f32 v[64:65], v[64:65], v[68:69]
  v_pk_add_f32 v[66:67], v[66:67], v[70:71]
  v_pk_add_f32 v[56:57], v[56:57], v[64:65]
  v_pk_add_f32 v[58:59], v[58:59], v[66:67]
  v_cvt_pk_bf16_f32 v32, v56, v57
  v_cvt_pk_bf16_f32 v33, v58, v59
  buffer_store_dwordx2 v[32:33], v152, s[60:63], 0 offen offset:2048
L_done:
  s_endpgm
L_rest:
  s_add_u32 s15, s14, 4096
  s_add_u32 m0, s15, 0
  s_nop 0
  buffer_load_dwordx4 v138, s[44:47], s15 offen nt lds
  s_add_u32 s15, s14, 4096
  s_add_u32 m0, s15, 16384
  s_nop 0
  buffer_load_dwordx4 v138, s[48:51], s15 offen nt lds
  s_add_u32 s15, s14, 8192
  s_add_u32 m0, s15, 0
  s_nop 0
  buffer_load_dwordx4 v138, s[44:47], s15 offen nt lds
  s_add_u32 s15, s14, 8192
  s_add_u32 m0, s15, 16384
  s_nop 0
  buffer_load_dwordx4 v138, s[48:51], s15 offen nt lds
  s_add_u32 s15, s14, 12288
  s_add_u32 m0, s15, 0
  s_nop 0
  buffer_load_dwordx4 v138, s[44:47], s15 offen nt lds
  s_add_u32 s15, s14, 12288
  s_add_u32 m0, s15, 16384
  s_nop 0
  buffer_load_dwordx4 v138, s[48:51], s15 offen nt lds
  buffer_load_dwordx2 v[140:141], v137, s[40:43], 0 offen offset:2048 nt
  buffer_load_dwordx2 v[142:143], v137, s[40:43], 0 offen offset:2112 nt
  buffer_load_dwordx2 v[144:145], v137, s[40:43], 0 offen offset:2176 nt
  buffer_load_dwordx2 v[146:147], v137, s[40:43], 0 offen offset:2240 nt
  s_add_u32 s15, s14, 0
  s_add_u32 m0, s15, 32768
  s_nop 0
  buffer_load_dwordx4 v138, s[52:55], s15 offen nt lds
  s_add_u32 s15, s14, 0
  s_add_u32 m0, s15, 40960
  s_nop 0
  buffer_load_dwordx4 v138, s[56:59], s15 offen nt lds
  s_add_u32 s15, s14, 4096
  s_add_u32 m0, s15, 32768
  s_nop 0
  buffer_load_dwordx4 v138, s[52:55], s15 offen nt lds
  s_add_u32 s15, s14, 4096
  s_add_u32 m0, s15, 40960
  s_nop 0
  buffer_load_dwordx4 v138, s[56:59], s15 offen nt lds
  s_branch L_k4
.section .rodata,"a"
.p2align 6
.amdhsa_kernel standalone__kv_cache_quant_int4_int2_kv_with_per_channel_or_per_token_scales__sampling_kernel
  .amdhsa_next_free_vgpr 256
  .amdhsa_next_free_sgpr 96
  .amdhsa_accum_offset 256
  .amdhsa_group_segment_fixed_size 0
  .amdhsa_kernarg_size 80
  .amdhsa_user_sgpr_count 2
  .amdhsa_user_sgpr_kernarg_segment_ptr 1
  .amdhsa_system_sgpr_workgroup_id_x 1
.end_amdhsa_kernel
```
